```python
import torch

def _softmax(x, axis=-1):
    return torch.softmax(x, dim=axis)
def _gelu(x):
    return torch.nn.functional.gelu(x, approximate="tanh")
def _silu(x):
    return torch.nn.functional.silu(x)
def _sigmoid(x):
    return torch.sigmoid(x)
def _layernorm(x, axis=-1, eps=1e-5):
    m = x.mean(dim=axis, keepdim=True)
    v = x.var(dim=axis, keepdim=True, unbiased=False)
    return (x - m) / torch.sqrt(v + eps)
def _scatter_add(tgt, idx, src, axis=0):
    return tgt.clone().index_add_(axis, idx, src)
def _segment_sum(src, seg, n):
    out = torch.zeros((n,) + src.shape[1:], dtype=src.dtype)
    return out.index_add_(0, seg, src)
def _pad(x, pw):
    flat = tuple(v for pair in reversed(pw) for v in pair)
    return torch.nn.functional.pad(x, flat)

kernel_name = 'standalone__paged_block_table_kv_pagedattention__decode'

def setup_inputs():

    _w = (lambda a: (lambda t: t.to(torch.bfloat16) if t.is_floating_point() else t)(torch.as_tensor(a)))
    B, Hq, Hkv, Sq, Skv, D = 2, 32, 16, 1, 8192, 128
    bs = 16
    nbps = max(1, Skv // bs)
    num_phys = B * nbps + 4
    bt = torch.randperm(num_phys)[: B * nbps].reshape(B, nbps).to(torch.int64)
    cl = (nbps * bs - (torch.arange(1, B + 1, dtype=torch.int64) * 2654435761) % max(1, nbps * bs // 2)).to(torch.int64)
    return {
        "q": _w((lambda *s: torch.randn(*s, dtype=torch.bfloat16) * 0.8)(B, Hq, Sq, D)),
        "k_cache": _w((lambda *s: torch.randn(*s, dtype=torch.bfloat16) * 0.8)(num_phys, bs, Hkv, D)),
        "v_cache": _w((lambda *s: torch.randn(*s, dtype=torch.bfloat16) * 0.05)(num_phys, bs, Hkv, D)),
        "block_table": _w(bt),
        "context_lens": _w(cl),
    }

def reference(q, k_cache, v_cache, block_table, context_lens):
    B, Hq, Sq, D = q.shape
    bs = k_cache.shape[1]
    Hkv = k_cache.shape[2]
    nbps = block_table.shape[1]
    Skv = nbps * bs
    bt = block_table.reshape(-1)
    k = (lambda x, *d: x.permute(*d))(k_cache[bt].reshape(B, Skv, Hkv, D), 0, 2, 1, 3)
    v = (lambda x, *d: x.permute(*d))(v_cache[bt].reshape(B, Skv, Hkv, D), 0, 2, 1, 3)
    g = Hq // Hkv
    qg = q.reshape(B, Hkv, g, Sq, D)
    scores = torch.einsum("bhgqd,bhkd->bhgqk", qg, k) * (D ** -0.5)
    pos = torch.arange(Skv)
    msk = pos[None, :] < context_lens[:, None]
    scores = torch.where(msk[:, None, None, None, :], scores, -1e9)
    p = _softmax(scores, axis=-1)
    out = torch.einsum("bhgqk,bhkd->bhgqd", p, v)
    return out.reshape(B, Hq, Sq, D)
```

```asm
; @launch grid=(256,1,1) block=(1024,1,1) lds=153088
.amdgcn_target "amdgcn-amd-amdhsa--gfx950"
.text
.globl standalone__paged_block_table_kv_pagedattention__decode_kernel
.p2align 8
.type standalone__paged_block_table_kv_pagedattention__decode_kernel,@function
standalone__paged_block_table_kv_pagedattention__decode_kernel:
  s_cmp_ge_u32 s2, 256
  s_cbranch_scc1 L_exit
  s_load_dwordx16 s[4:19], s[0:1], 0
  s_memrealtime s[98:99]
  v_lshrrev_b32 v33, 6, v0
  v_and_b32 v0, 63, v0
  v_readfirstlane_b32 s82, v33
  v_mov_b32 v8, 0
  v_mov_b32 v9, 0
  ds_write_b64 v8, v[8:9] offset:0
  s_lshr_b32 s86, s2, 3
  s_and_b32 s87, s2, 7
  s_and_b32 s83, s82, 1
  s_lshr_b32 s84, s82, 1
  s_lshl_b32 s85, s87, 1
  s_add_u32 s85, s85, s83
  s_lshl_b32 s96, s85, 8
  v_lshrrev_b32 v33, 4, v0
  v_and_b32 v32, 3, v0
  v_lshlrev_b32 v32, 4, v32
  v_lshl_add_u32 v32, v33, 6, v32
  v_bfe_u32 v1, v0, 2, 2
  v_lshl_add_u32 v1, v1, 12, v32
  v_add_u32 v1, s96, v1
  v_and_b32 v2, 15, v0
  v_lshlrev_b32 v2, 4, v2
  v_lshl_add_u32 v2, v33, 12, v2
  v_add_u32 v2, s96, v2
  v_bfe_u32 v16, v0, 3, 1
  v_lshl_add_u32 v16, v16, 8, v32
  s_lshl_b32 s97, s85, 9
  v_add_u32 v16, s97, v16
  v_lshlrev_b32 v3, 1, v0
  s_mov_b32 s101, 0x40000000
  v_lshlrev_b32 v17, 4, v0
  s_lshl_b32 s97, s82, 10
  s_add_u32 s96, s97, 148480
  s_mov_b32 m0, s96
  v_lshlrev_b32 v19, 2, v0
  v_mov_b32 v20, s101
  v_mov_b32 v21, v33
  s_waitcnt lgkmcnt(0)
  s_load_dwordx2 s[80:81], s[12:13], 0
  s_mov_b32 s32, s10
  s_and_b32 s33, s11, 0xffff
  s_mov_b32 s34, 4096
  s_mov_b32 s35, 0x00020000
  s_cmp_ge_u32 s82, 4
  s_cbranch_scc1 L_nobt
  buffer_load_dwordx4 v17, s[32:35], s97 offen lds
L_nobt:
  s_mov_b32 s20, s6
  s_and_b32 s21, s7, 0xffff
  s_mov_b32 s22, 67371008
  s_mov_b32 s23, 0x00020000
  s_mov_b32 s24, s8
  s_and_b32 s25, s9, 0xffff
  s_mov_b32 s26, 67371008
  s_mov_b32 s27, 0x00020000
  s_mov_b32 s28, s4
  s_and_b32 s29, s5, 0xffff
  s_mov_b32 s30, 16384
  s_mov_b32 s31, 0x00020000
  s_mov_b32 s44, s16
  s_and_b32 s45, s17, 0xffff
  s_mov_b32 s46, 256
  s_mov_b32 s47, 0x00020000
  v_mov_b32 v30, s98
  s_mov_b32 s6, 0x3e0293ee
  s_mul_i32 s13, s82, 9216
  s_add_u32 s13, s13, 1024
  s_waitcnt vmcnt(0)
  s_barrier
  s_waitcnt lgkmcnt(0)
  s_cmp_lt_i32 s80, 1
  s_cselect_b32 s8, 0, -1
  s_cselect_b32 s80, 0x2000, s80
  s_min_i32 s80, s80, 0x2000
  s_cmp_lt_i32 s81, 1
  s_cselect_b32 s9, 0, -1
  s_cselect_b32 s81, 0x2000, s81
  s_min_i32 s81, s81, 0x2000
  s_add_u32 s88, s80, 15
  s_lshr_b32 s88, s88, 4
  s_add_u32 s89, s81, 15
  s_lshr_b32 s89, s89, 4
  s_add_u32 s90, s88, s89
  s_add_u32 s90, s90, 63
  s_lshr_b32 s90, s90, 6
  s_lshl_b32 s91, s90, 1
  v_mul_u32_u24 v33, s91, v0
  v_add_u32 v32, v33, v3
  v_cmp_gt_u32 vcc, s88, v33
  v_cmp_gt_u32 s[10:11], s89, v33
  v_cmp_gt_u32 s[96:97], s88, v32
  v_cmp_gt_u32 s[98:99], s89, v32
  s_nop 1
  s_bcnt1_i32_b64 s92, vcc
  s_bcnt1_i32_b64 s93, s[10:11]
  s_bcnt1_i32_b64 s96, s[96:97]
  s_bcnt1_i32_b64 s98, s[98:99]
  s_add_u32 s97, s92, s93
  s_add_u32 s99, s91, 2
  s_cmp_gt_u32 s97, 32
  s_cselect_b32 s92, s96, s92
  s_cselect_b32 s93, s98, s93
  s_cselect_b32 s91, s99, s91
  s_sub_u32 s96, 31, s86
  s_cmp_lt_u32 s86, s92
  s_cselect_b32 s94, 0, 1
  s_cselect_b32 s95, s86, s96
  s_cselect_b32 s3, s92, s93
  s_cselect_b32 s80, s80, s81
  s_cselect_b32 s7, s8, s9
  s_cmp_ge_u32 s95, s3
  s_cbranch_scc1 L_exit
  s_mul_i32 s88, s95, s91
  s_add_u32 s96, s88, s91
  s_lshl_b32 s96, s96, 4
  s_min_u32 s96, s96, s80
  s_lshl_b32 s97, s88, 4
  s_sub_u32 s89, s96, s97
  s_add_u32 s90, s89, 3
  s_lshr_b32 s90, s90, 2
  s_sub_i32 s96, s90, 95
  s_ashr_i32 s96, s96, 1
  s_max_i32 s96, s96, 4
  s_lshl_b32 s97, s96, 1
  s_sub_i32 s97, s90, s97
  s_max_i32 s97, s97, 0
  s_add_u32 s98, s97, 5
  s_mul_i32 s98, s98, 43691
  s_lshr_b32 s98, s98, 18
  s_mul_i32 s92, s84, s98
  s_sub_u32 s99, s84, 6
  s_mul_i32 s99, s99, s96
  s_add_u32 s99, s99, s97
  s_cmp_lt_u32 s84, 6
  s_cselect_b32 s92, s92, s99
  s_cselect_b32 s97, s97, s90
  s_cselect_b32 s96, s98, s96
  s_lshl_b32 s98, s94, 9
  s_add_u32 s98, s98, s88
  s_lshl_b32 s98, s98, 2
  s_add_u32 s98, s98, 148480
  v_add_u32 v33, s92, v0
  v_and_b32 v18, -4, v33
  v_add_u32 v18, s98, v18
  ds_read_b32 v18, v18
  s_sub_i32 s97, s97, s92
  s_max_i32 s97, s97, 0
  s_min_i32 s93, s97, s96
  s_lshl_b32 s96, s92, 2
  s_sub_i32 s96, s89, s96
  s_lshl_b32 s97, s93, 2
  s_min_i32 s100, s96, s97
  v_and_b32 v33, 3, v33
  v_lshlrev_b32 v33, 14, v33
  v_sub_u32 v3, s100, v21
  s_lshl_b32 s99, s94, 13
  s_mov_b32 m0, s13
  v_cmp_gt_i32 vcc, s100, v19
  s_or_b32 s96, s2, s82
  s_cmp_lg_u32 s96, 0
  s_cbranch_scc1 L_noepoch
  v_or_b32 v30, 1, v30
  v_mov_b32 v31, 0
  s_mov_b64 exec, 1
  buffer_atomic_cmpswap v[30:31], v8, s[44:47], 0 offen
  s_mov_b64 exec, -1
L_noepoch:
  s_waitcnt lgkmcnt(0)
  v_lshl_add_u32 v18, v18, 16, v33
  v_cndmask_b32 v18, v20, v18, vcc
  s_nop 0
  v_readlane_b32 s48, v18, 0
  v_readlane_b32 s50, v18, 1
  v_readlane_b32 s52, v18, 2
  v_readlane_b32 s54, v18, 3
  s_cmp_le_u32 s93, 4
  s_cbranch_scc1 L_short
  s_mov_b32 s36, s18
  buffer_load_dwordx4 v[4:7], v16, s[28:31], s99 offen
  v_readlane_b32 s56, v18, 4
  buffer_load_dwordx4 v[36:39], v1, s[20:23], s48 offen nt
  v_readlane_b32 s58, v18, 5
  buffer_load_dwordx4 v[40:43], v1, s[20:23], s50 offen nt
  v_readlane_b32 s60, v18, 6
  buffer_load_dwordx4 v[44:47], v1, s[20:23], s52 offen nt
  v_readlane_b32 s62, v18, 7
  buffer_load_dwordx4 v[48:51], v1, s[20:23], s54 offen nt
  v_readlane_b32 s64, v18, 8
  buffer_load_dwordx4 v[52:55], v1, s[20:23], s56 offen nt
  v_readlane_b32 s66, v18, 9
  buffer_load_dwordx4 v[56:59], v1, s[20:23], s58 offen nt
  v_readlane_b32 s68, v18, 10
  buffer_load_dwordx4 v[60:63], v1, s[20:23], s60 offen nt
  v_readlane_b32 s70, v18, 11
  buffer_load_dwordx4 v[64:67], v1, s[20:23], s62 offen nt
  v_readlane_b32 s72, v18, 12
  buffer_load_dwordx4 v[68:71], v1, s[20:23], s64 offen nt
  v_readlane_b32 s74, v18, 13
  buffer_load_dwordx4 v[72:75], v1, s[20:23], s66 offen nt
  v_readlane_b32 s76, v18, 14
  buffer_load_dwordx4 v[76:79], v1, s[20:23], s68 offen nt
  v_readlane_b32 s78, v18, 15
  buffer_load_dwordx4 v[80:83], v1, s[20:23], s70 offen nt
  s_and_b32 s37, s19, 0xffff
  buffer_load_dwordx4 v[84:87], v1, s[20:23], s72 offen nt
  s_mov_b32 s38, 4194304
  buffer_load_dwordx4 v[88:91], v1, s[20:23], s74 offen nt
  s_mov_b32 s39, 0x00020000
  buffer_load_dwordx4 v[92:95], v1, s[20:23], s76 offen nt
  s_mov_b32 s40, s14
  buffer_load_dwordx4 v[96:99], v1, s[20:23], s78 offen nt
  s_and_b32 s41, s15, 0xffff
  buffer_load_dwordx4 v2, s[24:27], s48 offen nt lds
  s_add_u32 m0, m0, 1024
  s_mov_b32 s42, 16384
  buffer_load_dwordx4 v2, s[24:27], s50 offen nt lds
  s_add_u32 m0, m0, 1024
  s_mov_b32 s43, 0x00020000
  buffer_load_dwordx4 v2, s[24:27], s52 offen nt lds
  s_add_u32 m0, m0, 1024
  s_lshl_b32 s5, s94, 4
  buffer_load_dwordx4 v2, s[24:27], s54 offen nt lds
  s_add_u32 m0, m0, 1024
  s_add_u32 s5, s5, s85
  buffer_load_dwordx4 v2, s[24:27], s56 offen nt lds
  s_add_u32 m0, m0, 1024
  s_lshl_b32 s12, s5, 16
  buffer_load_dwordx4 v2, s[24:27], s58 offen nt lds
  s_add_u32 m0, m0, 1024
  s_lshl_b32 s4, s95, 11
  buffer_load_dwordx4 v2, s[24:27], s60 offen nt lds
  s_add_u32 m0, m0, 1024
  s_add_u32 s4, s4, s12
  buffer_load_dwordx4 v2, s[24:27], s62 offen nt lds
  s_add_u32 m0, m0, 1024
  v_mov_b32 v32, 0xfe800000
  buffer_load_dwordx4 v2, s[24:27], s64 offen nt lds
  v_lshlrev_b32 v1, 4, v0
  buffer_load_dwordx4 v[100:103], v2, s[24:27], s66 offen nt
  v_add_u32 v1, s13, v1
  buffer_load_dwordx4 v[104:107], v2, s[24:27], s68 offen nt
  s_lshl_b32 s92, s83, 7
  buffer_load_dwordx4 v[108:111], v2, s[24:27], s70 offen nt
  s_lshl_b32 s93, s84, 2
  buffer_load_dwordx4 v[112:115], v2, s[24:27], s72 offen nt
  s_add_u32 s92, s92, s93
  buffer_load_dwordx4 v[116:119], v2, s[24:27], s74 offen nt
  s_lshl_b32 s93, s83, 2
  buffer_load_dwordx4 v[120:123], v2, s[24:27], s76 offen nt
  s_lshl_b32 s90, 1, s84
  buffer_load_dwordx4 v[124:127], v2, s[24:27], s78 offen nt
  s_waitcnt vmcnt(32)
  v_and_b32 v4, s7, v4
  v_and_b32 v5, s7, v5
  v_and_b32 v6, s7, v6
  v_and_b32 v7, s7, v7
  s_nop 0
  s_waitcnt vmcnt(31)
  v_mfma_f32_16x16x32_bf16 v[8:11], v[36:39], v[4:7], 0
  s_nop 5
  s_waitcnt vmcnt(30)
  v_mfma_f32_16x16x32_bf16 v[12:15], v[40:43], v[4:7], 0
  v_cmp_lt_i32 vcc, 0, v3
  v_mov_b32_dpp v33, v8 quad_perm:[0,0,0,0] row_mask:0xf bank_mask:0xf
  v_add_f32_dpp v33, v9, v33 quad_perm:[1,1,1,1] row_mask:0xf bank_mask:0xf
  v_add_f32_dpp v33, v10, v33 quad_perm:[2,2,2,2] row_mask:0xf bank_mask:0xf
  v_add_f32_dpp v33, v11, v33 quad_perm:[3,3,3,3] row_mask:0xf bank_mask:0xf
  v_cndmask_b32 v16, v32, v33, vcc
  s_waitcnt vmcnt(29)
  v_mfma_f32_16x16x32_bf16 v[8:11], v[44:47], v[4:7], 0
  v_cmp_lt_i32 vcc, 4, v3
  v_mov_b32_dpp v33, v12 quad_perm:[0,0,0,0] row_mask:0xf bank_mask:0xf
  v_add_f32_dpp v33, v13, v33 quad_perm:[1,1,1,1] row_mask:0xf bank_mask:0xf
  v_add_f32_dpp v33, v14, v33 quad_perm:[2,2,2,2] row_mask:0xf bank_mask:0xf
  v_add_f32_dpp v33, v15, v33 quad_perm:[3,3,3,3] row_mask:0xf bank_mask:0xf
  v_cndmask_b32 v17, v32, v33, vcc
  s_waitcnt vmcnt(28)
  v_mfma_f32_16x16x32_bf16 v[12:15], v[48:51], v[4:7], 0
  v_cmp_lt_i32 vcc, 8, v3
  v_mov_b32_dpp v33, v8 quad_perm:[0,0,0,0] row_mask:0xf bank_mask:0xf
  v_add_f32_dpp v33, v9, v33 quad_perm:[1,1,1,1] row_mask:0xf bank_mask:0xf
  v_add_f32_dpp v33, v10, v33 quad_perm:[2,2,2,2] row_mask:0xf bank_mask:0xf
  v_add_f32_dpp v33, v11, v33 quad_perm:[3,3,3,3] row_mask:0xf bank_mask:0xf
  v_cndmask_b32 v18, v32, v33, vcc
  s_waitcnt vmcnt(27)
  v_mfma_f32_16x16x32_bf16 v[8:11], v[52:55], v[4:7], 0
  v_cmp_lt_i32 vcc, 12, v3
  v_mov_b32_dpp v33, v12 quad_perm:[0,0,0,0] row_mask:0xf bank_mask:0xf
  v_add_f32_dpp v33, v13, v33 quad_perm:[1,1,1,1] row_mask:0xf bank_mask:0xf
  v_add_f32_dpp v33, v14, v33 quad_perm:[2,2,2,2] row_mask:0xf bank_mask:0xf
  v_add_f32_dpp v33, v15, v33 quad_perm:[3,3,3,3] row_mask:0xf bank_mask:0xf
  v_cndmask_b32 v19, v32, v33, vcc
  s_waitcnt vmcnt(26)
  v_mfma_f32_16x16x32_bf16 v[12:15], v[56:59], v[4:7], 0
  v_cmp_lt_i32 vcc, 16, v3
  v_mov_b32_dpp v33, v8 quad_perm:[0,0,0,0] row_mask:0xf bank_mask:0xf
  v_add_f32_dpp v33, v9, v33 quad_perm:[1,1,1,1] row_mask:0xf bank_mask:0xf
  v_add_f32_dpp v33, v10, v33 quad_perm:[2,2,2,2] row_mask:0xf bank_mask:0xf
  v_add_f32_dpp v33, v11, v33 quad_perm:[3,3,3,3] row_mask:0xf bank_mask:0xf
  v_cndmask_b32 v20, v32, v33, vcc
  s_waitcnt vmcnt(25)
  v_mfma_f32_16x16x32_bf16 v[8:11], v[60:63], v[4:7], 0
  v_cmp_lt_i32 vcc, 20, v3
  v_mov_b32_dpp v33, v12 quad_perm:[0,0,0,0] row_mask:0xf bank_mask:0xf
  v_add_f32_dpp v33, v13, v33 quad_perm:[1,1,1,1] row_mask:0xf bank_mask:0xf
  v_add_f32_dpp v33, v14, v33 quad_perm:[2,2,2,2] row_mask:0xf bank_mask:0xf
  v_add_f32_dpp v33, v15, v33 quad_perm:[3,3,3,3] row_mask:0xf bank_mask:0xf
  v_cndmask_b32 v21, v32, v33, vcc
  s_waitcnt vmcnt(24)
  v_mfma_f32_16x16x32_bf16 v[12:15], v[64:67], v[4:7], 0
  v_cmp_lt_i32 vcc, 24, v3
  v_mov_b32_dpp v33, v8 quad_perm:[0,0,0,0] row_mask:0xf bank_mask:0xf
  v_add_f32_dpp v33, v9, v33 quad_perm:[1,1,1,1] row_mask:0xf bank_mask:0xf
  v_add_f32_dpp v33, v10, v33 quad_perm:[2,2,2,2] row_mask:0xf bank_mask:0xf
  v_add_f32_dpp v33, v11, v33 quad_perm:[3,3,3,3] row_mask:0xf bank_mask:0xf
  v_cndmask_b32 v22, v32, v33, vcc
  s_waitcnt vmcnt(23)
  v_mfma_f32_16x16x32_bf16 v[8:11], v[68:71], v[4:7], 0
  v_cmp_lt_i32 vcc, 28, v3
  v_mov_b32_dpp v33, v12 quad_perm:[0,0,0,0] row_mask:0xf bank_mask:0xf
  v_add_f32_dpp v33, v13, v33 quad_perm:[1,1,1,1] row_mask:0xf bank_mask:0xf
  v_add_f32_dpp v33, v14, v33 quad_perm:[2,2,2,2] row_mask:0xf bank_mask:0xf
  v_add_f32_dpp v33, v15, v33 quad_perm:[3,3,3,3] row_mask:0xf bank_mask:0xf
  v_cndmask_b32 v23, v32, v33, vcc
  s_waitcnt vmcnt(22)
  v_mfma_f32_16x16x32_bf16 v[12:15], v[72:75], v[4:7], 0
  v_cmp_lt_i32 vcc, 32, v3
  v_mov_b32_dpp v33, v8 quad_perm:[0,0,0,0] row_mask:0xf bank_mask:0xf
  v_add_f32_dpp v33, v9, v33 quad_perm:[1,1,1,1] row_mask:0xf bank_mask:0xf
  v_add_f32_dpp v33, v10, v33 quad_perm:[2,2,2,2] row_mask:0xf bank_mask:0xf
  v_add_f32_dpp v33, v11, v33 quad_perm:[3,3,3,3] row_mask:0xf bank_mask:0xf
  v_cndmask_b32 v24, v32, v33, vcc
  s_waitcnt vmcnt(21)
  v_mfma_f32_16x16x32_bf16 v[8:11], v[76:79], v[4:7], 0
  v_cmp_lt_i32 vcc, 36, v3
  v_mov_b32_dpp v33, v12 quad_perm:[0,0,0,0] row_mask:0xf bank_mask:0xf
  v_add_f32_dpp v33, v13, v33 quad_perm:[1,1,1,1] row_mask:0xf bank_mask:0xf
  v_add_f32_dpp v33, v14, v33 quad_perm:[2,2,2,2] row_mask:0xf bank_mask:0xf
  v_add_f32_dpp v33, v15, v33 quad_perm:[3,3,3,3] row_mask:0xf bank_mask:0xf
  v_cndmask_b32 v25, v32, v33, vcc
  s_waitcnt vmcnt(20)
  v_mfma_f32_16x16x32_bf16 v[12:15], v[80:83], v[4:7], 0
  v_cmp_lt_i32 vcc, 40, v3
  v_mov_b32_dpp v33, v8 quad_perm:[0,0,0,0] row_mask:0xf bank_mask:0xf
  v_add_f32_dpp v33, v9, v33 quad_perm:[1,1,1,1] row_mask:0xf bank_mask:0xf
  v_add_f32_dpp v33, v10, v33 quad_perm:[2,2,2,2] row_mask:0xf bank_mask:0xf
  v_add_f32_dpp v33, v11, v33 quad_perm:[3,3,3,3] row_mask:0xf bank_mask:0xf
  v_cndmask_b32 v26, v32, v33, vcc
  s_waitcnt vmcnt(19)
  v_mfma_f32_16x16x32_bf16 v[8:11], v[84:87], v[4:7], 0
  v_cmp_lt_i32 vcc, 44, v3
  v_mov_b32_dpp v33, v12 quad_perm:[0,0,0,0] row_mask:0xf bank_mask:0xf
  v_add_f32_dpp v33, v13, v33 quad_perm:[1,1,1,1] row_mask:0xf bank_mask:0xf
  v_add_f32_dpp v33, v14, v33 quad_perm:[2,2,2,2] row_mask:0xf bank_mask:0xf
  v_add_f32_dpp v33, v15, v33 quad_perm:[3,3,3,3] row_mask:0xf bank_mask:0xf
  v_cndmask_b32 v27, v32, v33, vcc
  s_waitcnt vmcnt(18)
  v_mfma_f32_16x16x32_bf16 v[12:15], v[88:91], v[4:7], 0
  v_cmp_lt_i32 vcc, 48, v3
  v_mov_b32_dpp v33, v8 quad_perm:[0,0,0,0] row_mask:0xf bank_mask:0xf
  v_add_f32_dpp v33, v9, v33 quad_perm:[1,1,1,1] row_mask:0xf bank_mask:0xf
  v_add_f32_dpp v33, v10, v33 quad_perm:[2,2,2,2] row_mask:0xf bank_mask:0xf
  v_add_f32_dpp v33, v11, v33 quad_perm:[3,3,3,3] row_mask:0xf bank_mask:0xf
  v_cndmask_b32 v28, v32, v33, vcc
  s_waitcnt vmcnt(17)
  v_mfma_f32_16x16x32_bf16 v[8:11], v[92:95], v[4:7], 0
  v_cmp_lt_i32 vcc, 52, v3
  v_mov_b32_dpp v33, v12 quad_perm:[0,0,0,0] row_mask:0xf bank_mask:0xf
  v_add_f32_dpp v33, v13, v33 quad_perm:[1,1,1,1] row_mask:0xf bank_mask:0xf
  v_add_f32_dpp v33, v14, v33 quad_perm:[2,2,2,2] row_mask:0xf bank_mask:0xf
  v_add_f32_dpp v33, v15, v33 quad_perm:[3,3,3,3] row_mask:0xf bank_mask:0xf
  v_cndmask_b32 v29, v32, v33, vcc
  s_waitcnt vmcnt(16)
  v_mfma_f32_16x16x32_bf16 v[12:15], v[96:99], v[4:7], 0
  v_cmp_lt_i32 vcc, 56, v3
  v_mov_b32_dpp v33, v8 quad_perm:[0,0,0,0] row_mask:0xf bank_mask:0xf
  v_add_f32_dpp v33, v9, v33 quad_perm:[1,1,1,1] row_mask:0xf bank_mask:0xf
  v_add_f32_dpp v33, v10, v33 quad_perm:[2,2,2,2] row_mask:0xf bank_mask:0xf
  v_add_f32_dpp v33, v11, v33 quad_perm:[3,3,3,3] row_mask:0xf bank_mask:0xf
  v_cndmask_b32 v30, v32, v33, vcc
  s_nop 1
  v_cmp_lt_i32 vcc, 60, v3
  v_mov_b32_dpp v33, v12 quad_perm:[0,0,0,0] row_mask:0xf bank_mask:0xf
  v_add_f32_dpp v33, v13, v33 quad_perm:[1,1,1,1] row_mask:0xf bank_mask:0xf
  v_add_f32_dpp v33, v14, v33 quad_perm:[2,2,2,2] row_mask:0xf bank_mask:0xf
  v_add_f32_dpp v33, v15, v33 quad_perm:[3,3,3,3] row_mask:0xf bank_mask:0xf
  v_cndmask_b32 v31, v32, v33, vcc
  v_max3_f32 v32, v16, v17, v18
  v_max3_f32 v32, v32, v19, v20
  v_max3_f32 v32, v32, v21, v22
  v_max3_f32 v32, v32, v23, v24
  v_max3_f32 v32, v32, v25, v26
  v_max3_f32 v32, v32, v27, v28
  v_max3_f32 v32, v32, v29, v30
  v_max_f32 v32, v32, v31
  v_mov_b32 v33, v32
  s_nop 1
  v_permlane32_swap_b32 v33, v32
  v_max_f32 v32, v32, v33
  v_mov_b32 v33, v32
  s_nop 1
  v_permlane16_swap_b32 v33, v32
  v_max_f32 v32, v32, v33
  v_mul_f32 v32, s6, v32
  v_fma_f32 v16, v16, s6, -v32
  v_fma_f32 v17, v17, s6, -v32
  v_fma_f32 v18, v18, s6, -v32
  v_fma_f32 v19, v19, s6, -v32
  v_fma_f32 v20, v20, s6, -v32
  v_fma_f32 v21, v21, s6, -v32
  v_fma_f32 v22, v22, s6, -v32
  v_fma_f32 v23, v23, s6, -v32
  v_fma_f32 v24, v24, s6, -v32
  v_fma_f32 v25, v25, s6, -v32
  v_fma_f32 v26, v26, s6, -v32
  v_fma_f32 v27, v27, s6, -v32
  v_fma_f32 v28, v28, s6, -v32
  v_fma_f32 v29, v29, s6, -v32
  v_fma_f32 v30, v30, s6, -v32
  v_fma_f32 v31, v31, s6, -v32
  v_exp_f32 v16, v16
  v_exp_f32 v17, v17
  v_exp_f32 v18, v18
  v_exp_f32 v19, v19
  v_exp_f32 v20, v20
  v_exp_f32 v21, v21
  v_exp_f32 v22, v22
  v_exp_f32 v23, v23
  v_exp_f32 v24, v24
  v_exp_f32 v25, v25
  v_exp_f32 v26, v26
  v_exp_f32 v27, v27
  v_exp_f32 v28, v28
  v_exp_f32 v29, v29
  v_exp_f32 v30, v30
  v_exp_f32 v31, v31
  v_bfe_u32 v9, v0, 3, 1
  v_lshlrev_b32 v9, 6, v9
  v_add_u32 v9, s92, v9
  ds_write_b32 v9, v32 offset:256
  v_add_f32 v8, v16, v17
  v_add_f32 v8, v8, v18
  v_add_f32 v8, v8, v19
  v_add_f32 v8, v8, v20
  v_add_f32 v8, v8, v21
  v_add_f32 v8, v8, v22
  v_add_f32 v8, v8, v23
  v_add_f32 v8, v8, v24
  v_add_f32 v8, v8, v25
  v_add_f32 v8, v8, v26
  v_add_f32 v8, v8, v27
  v_add_f32 v8, v8, v28
  v_add_f32 v8, v8, v29
  v_add_f32 v8, v8, v30
  v_add_f32 v8, v8, v31
  v_cvt_pk_bf16_f32 v16, v16, v16
  v_cvt_pk_bf16_f32 v17, v17, v17
  v_cvt_pk_bf16_f32 v18, v18, v18
  v_cvt_pk_bf16_f32 v19, v19, v19
  v_cvt_pk_bf16_f32 v20, v20, v20
  v_cvt_pk_bf16_f32 v21, v21, v21
  v_cvt_pk_bf16_f32 v22, v22, v22
  v_cvt_pk_bf16_f32 v23, v23, v23
  v_cvt_pk_bf16_f32 v24, v24, v24
  v_cvt_pk_bf16_f32 v25, v25, v25
  v_cvt_pk_bf16_f32 v26, v26, v26
  v_cvt_pk_bf16_f32 v27, v27, v27
  v_cvt_pk_bf16_f32 v28, v28, v28
  v_cvt_pk_bf16_f32 v29, v29, v29
  v_cvt_pk_bf16_f32 v30, v30, v30
  v_cvt_pk_bf16_f32 v31, v31, v31
  v_mov_b32 v33, v8
  s_nop 1
  v_permlane32_swap_b32 v33, v8
  v_add_f32 v8, v8, v33
  v_mov_b32 v33, v8
  s_nop 1
  v_permlane16_swap_b32 v33, v8
  v_add_f32 v8, v8, v33
  ds_write_b32 v9, v8 offset:512
  v_and_b32 v33, 1, v0
  v_cmp_eq_u32 vcc, 1, v33
  v_mov_b32 v33, 0xffff
  v_mov_b32 v32, 0xffff0000
  v_cndmask_b32 v33, v33, v32, vcc
  v_bfe_u32 v32, v0, 1, 2
  v_cmp_eq_u32 vcc, 0, v32
  v_cmp_eq_u32 s[8:9], 1, v32
  v_cmp_eq_u32 s[10:11], 2, v32
  v_cmp_eq_u32 s[96:97], 3, v32
  v_cndmask_b32 v34, 0, v33, vcc
  v_cndmask_b32 v35, 0, v33, s[8:9]
  v_cndmask_b32 v2, 0, v33, s[10:11]
  v_cndmask_b32 v3, 0, v33, s[96:97]
  v_mov_b32 v32, s93
  v_mov_b32 v33, s90
  s_waitcnt lgkmcnt(0)
  s_waitcnt vmcnt(15)
  ds_read_b128 v[36:39], v1 offset:0
  s_waitcnt vmcnt(14)
  ds_read_b128 v[40:43], v1 offset:1024
  s_waitcnt vmcnt(13)
  ds_read_b128 v[44:47], v1 offset:2048
  s_waitcnt vmcnt(12)
  ds_read_b128 v[48:51], v1 offset:3072
  s_waitcnt vmcnt(11)
  ds_read_b128 v[52:55], v1 offset:4096
  s_waitcnt vmcnt(10)
  ds_read_b128 v[56:59], v1 offset:5120
  s_waitcnt vmcnt(9)
  ds_read_b128 v[60:63], v1 offset:6144
  s_waitcnt vmcnt(8)
  ds_read_b128 v[64:67], v1 offset:7168
  s_waitcnt vmcnt(7)
  ds_read_b128 v[68:71], v1 offset:8192
  v_and_b32 v8, v16, v34
  v_and_b32 v9, v16, v35
  v_and_b32 v10, v16, v2
  v_and_b32 v11, v16, v3
  s_nop 0
  s_waitcnt lgkmcnt(8)
  v_mfma_f32_16x16x32_bf16 v[4:7], v[8:11], v[36:39], 0
  v_and_b32 v12, v17, v34
  v_and_b32 v13, v17, v35
  v_and_b32 v14, v17, v2
  v_and_b32 v15, v17, v3
  s_nop 0
  s_waitcnt lgkmcnt(7)
  v_mfma_f32_16x16x32_bf16 v[4:7], v[12:15], v[40:43], v[4:7]
  v_and_b32 v8, v18, v34
  v_and_b32 v9, v18, v35
  v_and_b32 v10, v18, v2
  v_and_b32 v11, v18, v3
  s_nop 0
  s_waitcnt lgkmcnt(6)
  v_mfma_f32_16x16x32_bf16 v[4:7], v[8:11], v[44:47], v[4:7]
  v_and_b32 v12, v19, v34
  v_and_b32 v13, v19, v35
  v_and_b32 v14, v19, v2
  v_and_b32 v15, v19, v3
  s_nop 0
  s_waitcnt lgkmcnt(5)
  v_mfma_f32_16x16x32_bf16 v[4:7], v[12:15], v[48:51], v[4:7]
  v_and_b32 v8, v20, v34
  v_and_b32 v9, v20, v35
  v_and_b32 v10, v20, v2
  v_and_b32 v11, v20, v3
  s_nop 0
  s_waitcnt lgkmcnt(4)
  v_mfma_f32_16x16x32_bf16 v[4:7], v[8:11], v[52:55], v[4:7]
  v_and_b32 v12, v21, v34
  v_and_b32 v13, v21, v35
  v_and_b32 v14, v21, v2
  v_and_b32 v15, v21, v3
  s_nop 0
  s_waitcnt lgkmcnt(3)
  v_mfma_f32_16x16x32_bf16 v[4:7], v[12:15], v[56:59], v[4:7]
  v_and_b32 v8, v22, v34
  v_and_b32 v9, v22, v35
  v_and_b32 v10, v22, v2
  v_and_b32 v11, v22, v3
  s_nop 0
  s_waitcnt lgkmcnt(2)
  v_mfma_f32_16x16x32_bf16 v[4:7], v[8:11], v[60:63], v[4:7]
  v_and_b32 v12, v23, v34
  v_and_b32 v13, v23, v35
  v_and_b32 v14, v23, v2
  v_and_b32 v15, v23, v3
  s_nop 0
  s_waitcnt lgkmcnt(1)
  v_mfma_f32_16x16x32_bf16 v[4:7], v[12:15], v[64:67], v[4:7]
  v_and_b32 v8, v24, v34
  v_and_b32 v9, v24, v35
  v_and_b32 v10, v24, v2
  v_and_b32 v11, v24, v3
  s_nop 0
  s_waitcnt lgkmcnt(0)
  v_mfma_f32_16x16x32_bf16 v[4:7], v[8:11], v[68:71], v[4:7]
  v_and_b32 v12, v25, v34
  v_and_b32 v13, v25, v35
  v_and_b32 v14, v25, v2
  v_and_b32 v15, v25, v3
  s_nop 0
  s_waitcnt vmcnt(6)
  v_mfma_f32_16x16x32_bf16 v[4:7], v[12:15], v[100:103], v[4:7]
  v_and_b32 v8, v26, v34
  v_and_b32 v9, v26, v35
  v_and_b32 v10, v26, v2
  v_and_b32 v11, v26, v3
  s_nop 0
  s_waitcnt vmcnt(5)
  v_mfma_f32_16x16x32_bf16 v[4:7], v[8:11], v[104:107], v[4:7]
  v_and_b32 v12, v27, v34
  v_and_b32 v13, v27, v35
  v_and_b32 v14, v27, v2
  v_and_b32 v15, v27, v3
  s_nop 0
  s_waitcnt vmcnt(4)
  v_mfma_f32_16x16x32_bf16 v[4:7], v[12:15], v[108:111], v[4:7]
  v_and_b32 v8, v28, v34
  v_and_b32 v9, v28, v35
  v_and_b32 v10, v28, v2
  v_and_b32 v11, v28, v3
  s_nop 0
  s_waitcnt vmcnt(3)
  v_mfma_f32_16x16x32_bf16 v[4:7], v[8:11], v[112:115], v[4:7]
  v_and_b32 v12, v29, v34
  v_and_b32 v13, v29, v35
  v_and_b32 v14, v29, v2
  v_and_b32 v15, v29, v3
  s_nop 0
  s_waitcnt vmcnt(2)
  v_mfma_f32_16x16x32_bf16 v[4:7], v[12:15], v[116:119], v[4:7]
  v_and_b32 v8, v30, v34
  v_and_b32 v9, v30, v35
  v_and_b32 v10, v30, v2
  v_and_b32 v11, v30, v3
  s_nop 0
  s_waitcnt vmcnt(1)
  v_mfma_f32_16x16x32_bf16 v[4:7], v[8:11], v[120:123], v[4:7]
  v_and_b32 v12, v31, v34
  v_and_b32 v13, v31, v35
  v_and_b32 v14, v31, v2
  v_and_b32 v15, v31, v3
  s_nop 0
  s_waitcnt vmcnt(0)
  v_mfma_f32_16x16x32_bf16 v[4:7], v[12:15], v[124:127], v[4:7]
  s_branch L_pub
L_short:
  s_mov_b32 s36, s18
  buffer_load_dwordx4 v[4:7], v16, s[28:31], s99 offen
  s_and_b32 s37, s19, 0xffff
  buffer_load_dwordx4 v[36:39], v1, s[20:23], s48 offen nt
  s_mov_b32 s38, 4194304
  buffer_load_dwordx4 v[40:43], v1, s[20:23], s50 offen nt
  s_mov_b32 s39, 0x00020000
  buffer_load_dwordx4 v[44:47], v1, s[20:23], s52 offen nt
  s_mov_b32 s40, s14
  buffer_load_dwordx4 v[48:51], v1, s[20:23], s54 offen nt
  s_and_b32 s41, s15, 0xffff
  buffer_load_dwordx4 v[52:55], v2, s[24:27], s48 offen nt
  s_mov_b32 s42, 16384
  buffer_load_dwordx4 v[56:59], v2, s[24:27], s50 offen nt
  s_mov_b32 s43, 0x00020000
  buffer_load_dwordx4 v[60:63], v2, s[24:27], s52 offen nt
  s_lshl_b32 s5, s94, 4
  buffer_load_dwordx4 v[64:67], v2, s[24:27], s54 offen nt
  s_add_u32 s5, s5, s85
  s_lshl_b32 s12, s5, 16
  s_lshl_b32 s4, s95, 11
  s_add_u32 s4, s4, s12
  v_mov_b32 v32, 0xfe800000
  v_lshlrev_b32 v1, 4, v0
  v_add_u32 v1, s13, v1
  s_lshl_b32 s92, s83, 7
  s_lshl_b32 s93, s84, 2
  s_add_u32 s92, s92, s93
  s_lshl_b32 s93, s83, 2
  s_lshl_b32 s90, 1, s84
  s_waitcnt vmcnt(8)
  v_and_b32 v4, s7, v4
  v_and_b32 v5, s7, v5
  v_and_b32 v6, s7, v6
  v_and_b32 v7, s7, v7
  s_nop 0
  s_waitcnt vmcnt(7)
  v_mfma_f32_16x16x32_bf16 v[8:11], v[36:39], v[4:7], 0
  s_nop 5
  s_waitcnt vmcnt(6)
  v_mfma_f32_16x16x32_bf16 v[12:15], v[40:43], v[4:7], 0
  v_cmp_lt_i32 vcc, 0, v3
  v_mov_b32_dpp v33, v8 quad_perm:[0,0,0,0] row_mask:0xf bank_mask:0xf
  v_add_f32_dpp v33, v9, v33 quad_perm:[1,1,1,1] row_mask:0xf bank_mask:0xf
  v_add_f32_dpp v33, v10, v33 quad_perm:[2,2,2,2] row_mask:0xf bank_mask:0xf
  v_add_f32_dpp v33, v11, v33 quad_perm:[3,3,3,3] row_mask:0xf bank_mask:0xf
  v_cndmask_b32 v16, v32, v33, vcc
  s_waitcnt vmcnt(5)
  v_mfma_f32_16x16x32_bf16 v[8:11], v[44:47], v[4:7], 0
  v_cmp_lt_i32 vcc, 4, v3
  v_mov_b32_dpp v33, v12 quad_perm:[0,0,0,0] row_mask:0xf bank_mask:0xf
  v_add_f32_dpp v33, v13, v33 quad_perm:[1,1,1,1] row_mask:0xf bank_mask:0xf
  v_add_f32_dpp v33, v14, v33 quad_perm:[2,2,2,2] row_mask:0xf bank_mask:0xf
  v_add_f32_dpp v33, v15, v33 quad_perm:[3,3,3,3] row_mask:0xf bank_mask:0xf
  v_cndmask_b32 v17, v32, v33, vcc
  s_waitcnt vmcnt(4)
  v_mfma_f32_16x16x32_bf16 v[12:15], v[48:51], v[4:7], 0
  v_cmp_lt_i32 vcc, 8, v3
  v_mov_b32_dpp v33, v8 quad_perm:[0,0,0,0] row_mask:0xf bank_mask:0xf
  v_add_f32_dpp v33, v9, v33 quad_perm:[1,1,1,1] row_mask:0xf bank_mask:0xf
  v_add_f32_dpp v33, v10, v33 quad_perm:[2,2,2,2] row_mask:0xf bank_mask:0xf
  v_add_f32_dpp v33, v11, v33 quad_perm:[3,3,3,3] row_mask:0xf bank_mask:0xf
  v_cndmask_b32 v18, v32, v33, vcc
  s_nop 1
  v_cmp_lt_i32 vcc, 12, v3
  v_mov_b32_dpp v33, v12 quad_perm:[0,0,0,0] row_mask:0xf bank_mask:0xf
  v_add_f32_dpp v33, v13, v33 quad_perm:[1,1,1,1] row_mask:0xf bank_mask:0xf
  v_add_f32_dpp v33, v14, v33 quad_perm:[2,2,2,2] row_mask:0xf bank_mask:0xf
  v_add_f32_dpp v33, v15, v33 quad_perm:[3,3,3,3] row_mask:0xf bank_mask:0xf
  v_cndmask_b32 v19, v32, v33, vcc
  v_max3_f32 v32, v16, v17, v18
  v_max_f32 v32, v32, v19
  v_mov_b32 v33, v32
  s_nop 1
  v_permlane32_swap_b32 v33, v32
  v_max_f32 v32, v32, v33
  v_mov_b32 v33, v32
  s_nop 1
  v_permlane16_swap_b32 v33, v32
  v_max_f32 v32, v32, v33
  v_mul_f32 v32, s6, v32
  v_fma_f32 v16, v16, s6, -v32
  v_fma_f32 v17, v17, s6, -v32
  v_fma_f32 v18, v18, s6, -v32
  v_fma_f32 v19, v19, s6, -v32
  v_exp_f32 v16, v16
  v_exp_f32 v17, v17
  v_exp_f32 v18, v18
  v_exp_f32 v19, v19
  v_bfe_u32 v9, v0, 3, 1
  v_lshlrev_b32 v9, 6, v9
  v_add_u32 v9, s92, v9
  ds_write_b32 v9, v32 offset:256
  v_add_f32 v8, v16, v17
  v_add_f32 v8, v8, v18
  v_add_f32 v8, v8, v19
  v_cvt_pk_bf16_f32 v16, v16, v16
  v_cvt_pk_bf16_f32 v17, v17, v17
  v_cvt_pk_bf16_f32 v18, v18, v18
  v_cvt_pk_bf16_f32 v19, v19, v19
  v_mov_b32 v33, v8
  s_nop 1
  v_permlane32_swap_b32 v33, v8
  v_add_f32 v8, v8, v33
  v_mov_b32 v33, v8
  s_nop 1
  v_permlane16_swap_b32 v33, v8
  v_add_f32 v8, v8, v33
  ds_write_b32 v9, v8 offset:512
  v_and_b32 v33, 1, v0
  v_cmp_eq_u32 vcc, 1, v33
  v_mov_b32 v33, 0xffff
  v_mov_b32 v32, 0xffff0000
  v_cndmask_b32 v33, v33, v32, vcc
  v_bfe_u32 v32, v0, 1, 2
  v_cmp_eq_u32 vcc, 0, v32
  v_cmp_eq_u32 s[8:9], 1, v32
  v_cmp_eq_u32 s[10:11], 2, v32
  v_cmp_eq_u32 s[96:97], 3, v32
  v_cndmask_b32 v34, 0, v33, vcc
  v_cndmask_b32 v35, 0, v33, s[8:9]
  v_cndmask_b32 v2, 0, v33, s[10:11]
  v_cndmask_b32 v3, 0, v33, s[96:97]
  v_mov_b32 v32, s93
  v_mov_b32 v33, s90
  s_waitcnt lgkmcnt(0)
  v_and_b32 v8, v16, v34
  v_and_b32 v9, v16, v35
  v_and_b32 v10, v16, v2
  v_and_b32 v11, v16, v3
  s_nop 0
  s_waitcnt vmcnt(3)
  v_mfma_f32_16x16x32_bf16 v[4:7], v[8:11], v[52:55], 0
  v_and_b32 v12, v17, v34
  v_and_b32 v13, v17, v35
  v_and_b32 v14, v17, v2
  v_and_b32 v15, v17, v3
  s_nop 0
  s_waitcnt vmcnt(2)
  v_mfma_f32_16x16x32_bf16 v[4:7], v[12:15], v[56:59], v[4:7]
  v_and_b32 v8, v18, v34
  v_and_b32 v9, v18, v35
  v_and_b32 v10, v18, v2
  v_and_b32 v11, v18, v3
  s_nop 0
  s_waitcnt vmcnt(1)
  v_mfma_f32_16x16x32_bf16 v[4:7], v[8:11], v[60:63], v[4:7]
  v_and_b32 v12, v19, v34
  v_and_b32 v13, v19, v35
  v_and_b32 v14, v19, v2
  v_and_b32 v15, v19, v3
  s_nop 0
  s_waitcnt vmcnt(0)
  v_mfma_f32_16x16x32_bf16 v[4:7], v[12:15], v[64:67], v[4:7]
L_pub:
  s_add_u32 s96, s95, 1
  s_cmp_eq_u32 s96, s3
  s_cselect_b32 s51, 1, 0
  s_lshl_b32 s50, 1, s95
  s_sub_u32 s50, s50, 1
  s_sub_u32 s96, s84, 1
  s_lshl_b32 s96, 0x10204081, s96
  s_and_b32 s50, s50, s96
  ds_write_b128 v1, v[4:7]
  s_mov_b64 exec, 1
  ds_or_b32 v32, v33 offset:0
  s_mov_b64 exec, -1
  s_cmp_eq_u32 s84, 0
  s_cbranch_scc1 L_role
  s_cmp_eq_u32 s51, 0
  s_cbranch_scc1 L_end
  s_cmp_eq_u32 s50, 0
  s_cbranch_scc1 L_end
L_role:
  v_mov_b32 v10, 0
  s_mov_b32 s54, 0
L_ep:
  buffer_load_dword v35, v10, s[44:47], 0 offen sc1
  v_lshlrev_b32 v2, 4, v0
  v_lshrrev_b32 v33, 5, v0
  v_lshlrev_b32 v34, 4, v33
  v_lshlrev_b32 v3, 6, v33
  s_lshl_b32 s96, s83, 7
  v_add_u32 v3, s96, v3
  s_mov_b32 s66, 0x7060500
  s_mov_b32 s67, 0x7060501
  s_mov_b32 s68, 0x7060502
  s_mov_b32 s69, 0x7060503
  s_mov_b32 s52, 0x0c0c0400
  s_mov_b32 s53, 0x04000c0c
  v_mov_b32 v11, 0xfe800000
  v_mov_b32 v12, 0
  v_mov_b32 v16, 0
  v_mov_b32 v17, 0
  v_mov_b32 v18, 0
  v_mov_b32 v19, 0
  s_min_u32 s96, s95, 7
  s_lshl_b32 s96, 1, s96
  s_sub_u32 s96, s96, 1
  s_lshl_b32 s96, s96, 9
  s_cmp_lg_u32 s51, 0
  s_cselect_b32 s96, s96, 0
  s_or_b32 s70, s96, 0xff
  s_mov_b32 s55, 0
  v_lshlrev_b32 v30, 8, v33
  v_and_b32 v13, 15, v0
  v_lshl_add_u32 v30, v13, 4, v30
  v_bfe_u32 v13, v0, 4, 1
  v_lshl_add_u32 v30, v13, 3, v30
  s_lshl_b32 s74, s5, 9
  s_mov_b32 s76, 1
  s_mov_b32 s77, 1
  s_waitcnt vmcnt(0)
  v_readfirstlane_b32 s48, v35
  s_add_u32 s54, s54, 1
  s_cmp_gt_u32 s54, 0x8000
  s_cbranch_scc1 L_epd
  s_cmp_lg_u32 s48, 0
  s_cbranch_scc1 L_epd
  s_cmp_lg_u32 s54, 64
  s_cbranch_scc1 L_ep
  s_memrealtime s[98:99]
  s_waitcnt lgkmcnt(0)
  s_or_b32 s98, s98, 1
  v_mov_b32 v20, s98
  v_mov_b32 v21, 0
  s_mov_b64 exec, 1
  buffer_atomic_cmpswap v[20:21], v10, s[44:47], 0 offen
  s_mov_b64 exec, -1
  s_branch L_ep
L_epd:
  s_cmp_lg_u32 s84, 0
  s_cbranch_scc1 L_poller
L_floop:
  ds_read_b32 v10, v32 offset:0
  s_add_u32 s54, s54, 1
  s_cmp_gt_u32 s54, 0x100000
  s_cbranch_scc1 L_fdone
  s_waitcnt lgkmcnt(0)
  v_readfirstlane_b32 s71, v10
  s_andn2_b32 s71, s71, s55
  s_cbranch_scc0 L_floop
L_fnext:
  s_ff1_i32_b32 s96, s71
  s_bitset0_b32 s71, s96
  s_bitset1_b32 s55, s96
  s_and_b32 s97, s96, 7
  s_mul_i32 s97, s97, 18432
  s_lshr_b32 s98, s96, 3
  s_lshl_b32 s98, s98, 10
  s_add_u32 s97, s97, s98
  s_lshl_b32 s96, s96, 2
  v_add_u32 v20, s97, v1
  v_add_u32 v21, s96, v3
  ds_read_b32 v28, v21 offset:256
  ds_read_b32 v29, v21 offset:512
  ds_read_b128 v[24:27], v20
  s_waitcnt lgkmcnt(2)
  v_max_f32 v33, v11, v28
  v_sub_f32 v13, v11, v33
  v_sub_f32 v14, v28, v33
  v_exp_f32 v13, v13
  v_exp_f32 v14, v14
  v_mov_b32 v11, v33
  v_mul_f32 v12, v12, v13
  v_pk_mul_f32 v[16:17], v[16:17], v[12:13] op_sel:[0,1] op_sel_hi:[1,1]
  v_pk_mul_f32 v[18:19], v[18:19], v[12:13] op_sel:[0,1] op_sel_hi:[1,1]
  s_waitcnt lgkmcnt(0)
  v_fmac_f32 v12, v29, v14
  v_pk_fma_f32 v[16:17], v[24:25], v[14:15], v[16:17] op_sel:[0,0,0] op_sel_hi:[1,0,1]
  v_pk_fma_f32 v[18:19], v[26:27], v[14:15], v[18:19] op_sel:[0,0,0] op_sel_hi:[1,0,1]
  s_cmp_lg_u32 s71, 0
  s_cbranch_scc1 L_fnext
  s_cmp_lg_u32 s55, s70
  s_cbranch_scc1 L_floop
L_fdone:
  s_cmp_lg_u32 s51, 0
  s_cbranch_scc1 L_final
  v_perm_b32 v24, v16, v35, s66
  v_perm_b32 v25, v17, v35, s67
  v_perm_b32 v26, v18, v35, s68
  v_perm_b32 v27, v19, v35, s69
  buffer_store_dwordx4 v[24:27], v2, s[36:39], s4 offen sc1
  v_mov_b32 v20, v11
  v_mov_b32 v21, v12
  v_mov_b32 v22, v35
  v_mov_b32 v23, v35
  s_mov_b64 exec, s[76:77]
  buffer_store_dwordx4 v[20:23], v34, s[36:39], s4 offen offset:1024 sc1
  s_mov_b64 exec, -1
  s_branch L_end
L_final:
  v_rcp_f32 v12, v12
  s_nop 0
  v_pk_mul_f32 v[16:17], v[16:17], v[12:13] op_sel:[0,0] op_sel_hi:[1,0]
  v_pk_mul_f32 v[18:19], v[18:19], v[12:13] op_sel:[0,0] op_sel_hi:[1,0]
  v_cvt_pk_bf16_f32 v24, v16, v17
  v_cvt_pk_bf16_f32 v25, v18, v19
  buffer_store_dwordx2 v[24:25], v30, s[40:43], s74 offen
  s_branch L_end
L_poller:
  ds_read_b32 v10, v32 offset:0
  s_add_u32 s54, s54, 1
  s_cmp_gt_u32 s54, 0x40000
  s_cbranch_scc1 L_round
  s_waitcnt lgkmcnt(0)
  v_readfirstlane_b32 s96, v10
  s_and_b32 s96, s96, 0xff
  s_cmp_eq_u32 s96, 0xff
  s_cbranch_scc1 L_round
  s_sleep 2
  s_branch L_poller
L_round:
  s_add_u32 s54, s54, 1
  s_cmp_gt_u32 s54, 0x60000
  s_cbranch_scc1 L_pdone
  s_mov_b32 s64, s50
  s_ff1_i32_b32 s56, s64
  s_bitset0_b32 s64, s56
  s_lshl_b32 s96, s56, 11
  s_add_u32 s96, s96, s12
  buffer_load_dwordx4 v[36:39], v2, s[36:39], s96 offen sc1
  buffer_load_dwordx4 v[40:43], v34, s[36:39], s96 offen offset:1024 sc1
  s_mov_b32 s57, -1
  s_cmp_eq_u32 s64, 0
  s_cbranch_scc1 L_issued
  s_ff1_i32_b32 s57, s64
  s_bitset0_b32 s64, s57
  s_lshl_b32 s96, s57, 11
  s_add_u32 s96, s96, s12
  buffer_load_dwordx4 v[44:47], v2, s[36:39], s96 offen sc1
  buffer_load_dwordx4 v[48:51], v34, s[36:39], s96 offen offset:1024 sc1
  s_mov_b32 s58, -1
  s_cmp_eq_u32 s64, 0
  s_cbranch_scc1 L_issued
  s_ff1_i32_b32 s58, s64
  s_bitset0_b32 s64, s58
  s_lshl_b32 s96, s58, 11
  s_add_u32 s96, s96, s12
  buffer_load_dwordx4 v[52:55], v2, s[36:39], s96 offen sc1
  buffer_load_dwordx4 v[56:59], v34, s[36:39], s96 offen offset:1024 sc1
  s_mov_b32 s59, -1
  s_cmp_eq_u32 s64, 0
  s_cbranch_scc1 L_issued
  s_ff1_i32_b32 s59, s64
  s_bitset0_b32 s64, s59
  s_lshl_b32 s96, s59, 11
  s_add_u32 s96, s96, s12
  buffer_load_dwordx4 v[60:63], v2, s[36:39], s96 offen sc1
  buffer_load_dwordx4 v[64:67], v34, s[36:39], s96 offen offset:1024 sc1
  s_mov_b32 s60, -1
  s_cmp_eq_u32 s64, 0
  s_cbranch_scc1 L_issued
  s_ff1_i32_b32 s60, s64
  s_bitset0_b32 s64, s60
  s_lshl_b32 s96, s60, 11
  s_add_u32 s96, s96, s12
  buffer_load_dwordx4 v[68:71], v2, s[36:39], s96 offen sc1
  buffer_load_dwordx4 v[72:75], v34, s[36:39], s96 offen offset:1024 sc1
L_issued:
  s_waitcnt vmcnt(0)
  v_perm_b32 v13, v37, v36, s52
  v_perm_b32 v14, v39, v38, s53
  v_cmp_ne_u32 s[98:99], v35, v42
  v_cmp_ne_u32 s[8:9], v35, v43
  v_or_b32 v13, v13, v14
  v_cmp_ne_u32 vcc, v35, v13
  v_max_f32 v33, v11, v40
  s_or_b64 s[98:99], s[8:9], s[98:99]
  s_or_b64 s[98:99], vcc, s[98:99]
  s_cbranch_scc1 L_skip0
  v_sub_f32 v13, v11, v33
  v_sub_f32 v14, v40, v33
  v_exp_f32 v13, v13
  v_exp_f32 v14, v14
  v_mov_b32 v11, v33
  v_mul_f32 v12, v12, v13
  v_pk_mul_f32 v[16:17], v[16:17], v[12:13] op_sel:[0,1] op_sel_hi:[1,1]
  v_pk_mul_f32 v[18:19], v[18:19], v[12:13] op_sel:[0,1] op_sel_hi:[1,1]
  v_fmac_f32 v12, v41, v14
  v_pk_fma_f32 v[16:17], v[36:37], v[14:15], v[16:17] op_sel:[0,0,0] op_sel_hi:[1,0,1]
  v_pk_fma_f32 v[18:19], v[38:39], v[14:15], v[18:19] op_sel:[0,0,0] op_sel_hi:[1,0,1]
  s_bitset0_b32 s50, s56
L_skip0:
  s_cmp_lt_i32 s57, 0
  s_cbranch_scc1 L_rend
  v_perm_b32 v13, v45, v44, s52
  v_perm_b32 v14, v47, v46, s53
  v_cmp_ne_u32 s[98:99], v35, v50
  v_cmp_ne_u32 s[8:9], v35, v51
  v_or_b32 v13, v13, v14
  v_cmp_ne_u32 vcc, v35, v13
  v_max_f32 v33, v11, v48
  s_or_b64 s[98:99], s[8:9], s[98:99]
  s_or_b64 s[98:99], vcc, s[98:99]
  s_cbranch_scc1 L_skip1
  v_sub_f32 v13, v11, v33
  v_sub_f32 v14, v48, v33
  v_exp_f32 v13, v13
  v_exp_f32 v14, v14
  v_mov_b32 v11, v33
  v_mul_f32 v12, v12, v13
  v_pk_mul_f32 v[16:17], v[16:17], v[12:13] op_sel:[0,1] op_sel_hi:[1,1]
  v_pk_mul_f32 v[18:19], v[18:19], v[12:13] op_sel:[0,1] op_sel_hi:[1,1]
  v_fmac_f32 v12, v49, v14
  v_pk_fma_f32 v[16:17], v[44:45], v[14:15], v[16:17] op_sel:[0,0,0] op_sel_hi:[1,0,1]
  v_pk_fma_f32 v[18:19], v[46:47], v[14:15], v[18:19] op_sel:[0,0,0] op_sel_hi:[1,0,1]
  s_bitset0_b32 s50, s57
L_skip1:
  s_cmp_lt_i32 s58, 0
  s_cbranch_scc1 L_rend
  v_perm_b32 v13, v53, v52, s52
  v_perm_b32 v14, v55, v54, s53
  v_cmp_ne_u32 s[98:99], v35, v58
  v_cmp_ne_u32 s[8:9], v35, v59
  v_or_b32 v13, v13, v14
  v_cmp_ne_u32 vcc, v35, v13
  v_max_f32 v33, v11, v56
  s_or_b64 s[98:99], s[8:9], s[98:99]
  s_or_b64 s[98:99], vcc, s[98:99]
  s_cbranch_scc1 L_skip2
  v_sub_f32 v13, v11, v33
  v_sub_f32 v14, v56, v33
  v_exp_f32 v13, v13
  v_exp_f32 v14, v14
  v_mov_b32 v11, v33
  v_mul_f32 v12, v12, v13
  v_pk_mul_f32 v[16:17], v[16:17], v[12:13] op_sel:[0,1] op_sel_hi:[1,1]
  v_pk_mul_f32 v[18:19], v[18:19], v[12:13] op_sel:[0,1] op_sel_hi:[1,1]
  v_fmac_f32 v12, v57, v14
  v_pk_fma_f32 v[16:17], v[52:53], v[14:15], v[16:17] op_sel:[0,0,0] op_sel_hi:[1,0,1]
  v_pk_fma_f32 v[18:19], v[54:55], v[14:15], v[18:19] op_sel:[0,0,0] op_sel_hi:[1,0,1]
  s_bitset0_b32 s50, s58
L_skip2:
  s_cmp_lt_i32 s59, 0
  s_cbranch_scc1 L_rend
  v_perm_b32 v13, v61, v60, s52
  v_perm_b32 v14, v63, v62, s53
  v_cmp_ne_u32 s[98:99], v35, v66
  v_cmp_ne_u32 s[8:9], v35, v67
  v_or_b32 v13, v13, v14
  v_cmp_ne_u32 vcc, v35, v13
  v_max_f32 v33, v11, v64
  s_or_b64 s[98:99], s[8:9], s[98:99]
  s_or_b64 s[98:99], vcc, s[98:99]
  s_cbranch_scc1 L_skip3
  v_sub_f32 v13, v11, v33
  v_sub_f32 v14, v64, v33
  v_exp_f32 v13, v13
  v_exp_f32 v14, v14
  v_mov_b32 v11, v33
  v_mul_f32 v12, v12, v13
  v_pk_mul_f32 v[16:17], v[16:17], v[12:13] op_sel:[0,1] op_sel_hi:[1,1]
  v_pk_mul_f32 v[18:19], v[18:19], v[12:13] op_sel:[0,1] op_sel_hi:[1,1]
  v_fmac_f32 v12, v65, v14
  v_pk_fma_f32 v[16:17], v[60:61], v[14:15], v[16:17] op_sel:[0,0,0] op_sel_hi:[1,0,1]
  v_pk_fma_f32 v[18:19], v[62:63], v[14:15], v[18:19] op_sel:[0,0,0] op_sel_hi:[1,0,1]
  s_bitset0_b32 s50, s59
L_skip3:
  s_cmp_lt_i32 s60, 0
  s_cbranch_scc1 L_rend
  v_perm_b32 v13, v69, v68, s52
  v_perm_b32 v14, v71, v70, s53
  v_cmp_ne_u32 s[98:99], v35, v74
  v_cmp_ne_u32 s[8:9], v35, v75
  v_or_b32 v13, v13, v14
  v_cmp_ne_u32 vcc, v35, v13
  v_max_f32 v33, v11, v72
  s_or_b64 s[98:99], s[8:9], s[98:99]
  s_or_b64 s[98:99], vcc, s[98:99]
  s_cbranch_scc1 L_skip4
  v_sub_f32 v13, v11, v33
  v_sub_f32 v14, v72, v33
  v_exp_f32 v13, v13
  v_exp_f32 v14, v14
  v_mov_b32 v11, v33
  v_mul_f32 v12, v12, v13
  v_pk_mul_f32 v[16:17], v[16:17], v[12:13] op_sel:[0,1] op_sel_hi:[1,1]
  v_pk_mul_f32 v[18:19], v[18:19], v[12:13] op_sel:[0,1] op_sel_hi:[1,1]
  v_fmac_f32 v12, v73, v14
  v_pk_fma_f32 v[16:17], v[68:69], v[14:15], v[16:17] op_sel:[0,0,0] op_sel_hi:[1,0,1]
  v_pk_fma_f32 v[18:19], v[70:71], v[14:15], v[18:19] op_sel:[0,0,0] op_sel_hi:[1,0,1]
  s_bitset0_b32 s50, s60
L_skip4:
L_rend:
  s_cmp_lg_u32 s50, 0
  s_cbranch_scc1 L_round
L_pdone:
  s_lshl_b32 s96, s84, 2
  s_add_u32 s96, s96, 32
  v_add_u32 v21, s96, v3
  ds_write_b128 v1, v[16:19] offset:1024
  ds_write_b32 v21, v11 offset:256
  ds_write_b32 v21, v12 offset:512
  s_lshl_b32 s96, 0x100, s84
  v_mov_b32 v33, s96
  s_mov_b64 exec, 1
  ds_or_b32 v32, v33 offset:0
  s_mov_b64 exec, -1
L_end:
L_exit:
  s_endpgm
.section .rodata,"a"
.p2align 6
.amdhsa_kernel standalone__paged_block_table_kv_pagedattention__decode_kernel
  .amdhsa_next_free_vgpr 128
  .amdhsa_next_free_sgpr 102
  .amdhsa_accum_offset 128
  .amdhsa_group_segment_fixed_size 0
  .amdhsa_kernarg_size 64
  .amdhsa_user_sgpr_count 2
  .amdhsa_user_sgpr_kernarg_segment_ptr 1
  .amdhsa_system_sgpr_workgroup_id_x 1
.end_amdhsa_kernel
```
